```python
import torch

def _softmax(x, axis=-1):
    return torch.softmax(x, dim=axis)
def _gelu(x):
    return torch.nn.functional.gelu(x, approximate="tanh")
def _silu(x):
    return torch.nn.functional.silu(x)
def _sigmoid(x):
    return torch.sigmoid(x)
def _layernorm(x, axis=-1, eps=1e-5):
    m = x.mean(dim=axis, keepdim=True)
    v = x.var(dim=axis, keepdim=True, unbiased=False)
    return (x - m) / torch.sqrt(v + eps)
def _scatter_add(tgt, idx, src, axis=0):
    return tgt.clone().index_add_(axis, idx, src)
def _segment_sum(src, seg, n):
    out = torch.zeros((n,) + src.shape[1:], dtype=src.dtype)
    return out.index_add_(0, seg, src)
def _pad(x, pw):
    flat = tuple(v for pair in reversed(pw) for v in pair)
    return torch.nn.functional.pad(x, flat)

kernel_name = 'standalone__low_rank_proj_linformer__sampling'

def setup_inputs():

    _w = (lambda a: (lambda t: t.to(torch.bfloat16) if t.is_floating_point() else t)(torch.as_tensor(a)))
    B, H, Sq, Skv, Dh, R = 16, 32, 1, 2048, 128, 64
    return {
        "q": _w((lambda *s: torch.randn(*s, dtype=torch.bfloat16) * 0.8)(B, H, Sq, Dh)),
        "k": _w((lambda *s: torch.randn(*s, dtype=torch.bfloat16) * 0.8)(B, H, Skv, Dh)),
        "v": _w((lambda *s: torch.randn(*s, dtype=torch.bfloat16) * 0.05)(B, H, Skv, Dh)),
        "e_proj": _w((lambda *s: torch.randn(*s, dtype=torch.bfloat16) * 0.8)(R, Skv) * (Skv ** -0.5)),
        "f_proj": _w((lambda *s: torch.randn(*s, dtype=torch.bfloat16) * 0.05)(R, Skv) * (Skv ** -0.5)),
    }

def reference(q, k, v, e_proj, f_proj):
    B, H, Sq, Dh = q.shape
    kp = torch.einsum("rn,bhnd->bhrd", e_proj, k)
    vp = torch.einsum("rn,bhnd->bhrd", f_proj, v)
    scores = torch.einsum("bhqd,bhrd->bhqr", q, kp) * (Dh ** -0.5)
    p = _softmax(scores, axis=-1)
    o = torch.einsum("bhqr,bhrd->bhqd", p, vp)
    return o
```

```asm
; @launch grid=(256,1,1) block=(256,1,1) lds=98304
.amdgcn_target "amdgcn-amd-amdhsa--gfx950"
.text
.globl standalone__low_rank_proj_linformer__sampling_kernel
.p2align 8
.type standalone__low_rank_proj_linformer__sampling_kernel,@function
standalone__low_rank_proj_linformer__sampling_kernel:
    s_cmp_ge_u32 s2, 0x100
    s_cbranch_scc1 L_END
    s_load_dwordx16 s[4:19], s[0:1], 0
    v_lshrrev_b32 v15, 6, v0
    v_and_b32 v0, 63, v0
    v_readfirstlane_b32 s44, v15
    v_and_b32 v13, 15, v0
    v_lshrrev_b32 v14, 4, v0
    v_lshlrev_b32 v12, 4, v13
    v_lshl_add_u32 v1, v14, 11, v12
    v_lshl_add_u32 v1, v15, 13, v1
    s_lshl_b32 s58, s2, 20
    s_lshl_b32 s59, s2, 9
    s_mov_b32 s46, 0
    s_mov_b32 s47, 0x80000
    s_mov_b32 s48, 0x8000
    s_mov_b32 s49, 0x88000
    s_waitcnt lgkmcnt(0)
    s_mov_b32 s36, s4
    s_and_b32 s37, s5, 0xffff
    s_mov_b32 s38, 0x20000
    s_mov_b32 s39, 0x20000
    s_add_u32 s6, s6, s58
    s_addc_u32 s7, s7, 0
    s_mov_b32 s20, s6
    s_and_b32 s21, s7, 0xffff
    s_mov_b32 s22, 0x100000
    s_mov_b32 s23, 0x20000
    buffer_load_dwordx4 v[4:7], v12, s[36:39], s59 offen
    buffer_load_dwordx4 v[16:19], v1, s[20:23], s46 offen offset:0 nt
    buffer_load_dwordx4 v[20:23], v1, s[20:23], s46 offen offset:256 nt
    buffer_load_dwordx4 v[24:27], v1, s[20:23], s46 offen offset:512 nt
    buffer_load_dwordx4 v[28:31], v1, s[20:23], s46 offen offset:768 nt
    buffer_load_dwordx4 v[32:35], v1, s[20:23], s46 offen offset:1024 nt
    buffer_load_dwordx4 v[36:39], v1, s[20:23], s46 offen offset:1280 nt
    buffer_load_dwordx4 v[40:43], v1, s[20:23], s46 offen offset:1536 nt
    buffer_load_dwordx4 v[44:47], v1, s[20:23], s46 offen offset:1792 nt
    buffer_load_dwordx4 v[8:11], v12, s[36:39], s59 offen offset:256
    s_mov_b32 s60, 0x40000000
    buffer_load_dword v91, v12, s[36:39], s60 offen
    s_mov_b32 s24, s6
    s_and_b32 s25, s7, 0xffff
    s_mov_b32 s26, 0x100000
    s_mov_b32 s27, 0x20000
    s_mov_b32 s28, s10
    s_and_b32 s29, s11, 0xffff
    s_mov_b32 s30, 0x40000
    s_mov_b32 s31, 0x20000
    s_mov_b32 s32, s12
    s_and_b32 s33, s13, 0xffff
    s_mov_b32 s34, 0x40000
    s_mov_b32 s35, 0x20000
    v_lshlrev_b32 v2, 12, v13
    v_lshl_add_u32 v2, v15, 6, v2
    v_lshl_add_u32 v2, v14, 4, v2
    v_lshlrev_b32 v3, 14, v14
    v_lshl_add_u32 v3, v15, 8, v3
    v_lshl_add_u32 v3, v13, 4, v3
    s_add_u32 s56, s8, s58
    s_addc_u32 s57, s9, 0
    s_and_b32 s57, s57, 0xffff
    s_mov_b32 s40, s14
    s_and_b32 s41, s15, 0xffff
    s_mov_b32 s42, 0x20000
    s_mov_b32 s43, 0x20000
    s_mov_b32 s54, 0x05040100
    s_mov_b32 s55, 0x07060302
    s_mov_b32 s62, 0xffff0000
    s_mov_b32 s45, 0
    s_mov_b32 s50, 0
    s_mov_b32 s51, 0x40000000
    v_and_b32 v12, 1, v13
    s_lshl_b32 s60, s44, 6
    s_add_u32 s60, s60, 4096
    v_mul_u32_u24 v15, 4160, v12
    v_lshl_add_u32 v15, v14, 4, v15
    v_add_u32 v88, s60, v15
    s_lshl_b32 s60, s44, 8
    s_add_u32 s60, s60, 4096
    v_lshrrev_b32 v15, 1, v14
    v_mul_u32_u24 v15, 8320, v15
    v_lshl_add_u32 v15, v13, 4, v15
    v_add_u32 v89, s60, v15
    s_lshl_b32 s60, s44, 9
    s_add_u32 s60, s60, 2048
    v_lshrrev_b32 v15, 3, v13
    v_lshl_add_u32 v15, v15, 1, v12
    v_lshlrev_b32 v15, 7, v15
    v_lshl_add_u32 v15, v14, 3, v15
    v_add_u32 v14, s60, v15
    v_mov_b32 v12, v88
    v_mov_b32 v13, v89
    v_mov_b32 v204, 0
    v_mov_b32 v205, 0
    v_mov_b32 v206, 0
    v_mov_b32 v207, 0
    v_mov_b32 v208, 0
    v_mov_b32 v209, 0
    v_mov_b32 v210, 0
    v_mov_b32 v211, 0
    v_mov_b32 v212, 0
    v_mov_b32 v213, 0
    v_mov_b32 v214, 0
    v_mov_b32 v215, 0
    v_mov_b32 v216, 0
    v_mov_b32 v217, 0
    v_mov_b32 v218, 0
    v_mov_b32 v219, 0
    v_mov_b32 v220, 0
    v_mov_b32 v221, 0
    v_mov_b32 v222, 0
    v_mov_b32 v223, 0
    v_mov_b32 v224, 0
    v_mov_b32 v225, 0
    v_mov_b32 v226, 0
    v_mov_b32 v227, 0
    v_mov_b32 v228, 0
    v_mov_b32 v229, 0
    v_mov_b32 v230, 0
    v_mov_b32 v231, 0
    v_mov_b32 v232, 0
    v_mov_b32 v233, 0
    v_mov_b32 v234, 0
    v_mov_b32 v235, 0
    v_mov_b32 v236, 0
    v_mov_b32 v108, 0
    v_mov_b32 v237, 0
    v_mov_b32 v109, 0
    v_mov_b32 v238, 0
    v_mov_b32 v110, 0
    v_mov_b32 v239, 0
    v_mov_b32 v111, 0
    v_mov_b32 v240, 0
    v_mov_b32 v112, 0
    v_mov_b32 v241, 0
    v_mov_b32 v113, 0
    v_mov_b32 v242, 0
    v_mov_b32 v114, 0
    v_mov_b32 v243, 0
    v_mov_b32 v115, 0
    v_mov_b32 v244, 0
    v_mov_b32 v116, 0
    v_mov_b32 v245, 0
    v_mov_b32 v117, 0
    v_mov_b32 v246, 0
    v_mov_b32 v118, 0
    v_mov_b32 v247, 0
    v_mov_b32 v119, 0
    v_mov_b32 v248, 0
    v_mov_b32 v120, 0
    v_mov_b32 v249, 0
    v_mov_b32 v121, 0
    v_mov_b32 v250, 0
    v_mov_b32 v122, 0
    v_mov_b32 v251, 0
    v_mov_b32 v123, 0
    v_accvgpr_write_b32 a0, 0
    v_accvgpr_write_b32 a1, 0
    v_accvgpr_write_b32 a4, 0
    v_accvgpr_write_b32 a5, 0
    v_accvgpr_write_b32 a8, 0
    v_accvgpr_write_b32 a9, 0
    v_accvgpr_write_b32 a12, 0
    v_accvgpr_write_b32 a13, 0
    v_accvgpr_write_b32 a16, 0
    v_accvgpr_write_b32 a17, 0
    v_accvgpr_write_b32 a20, 0
    v_accvgpr_write_b32 a21, 0
    v_accvgpr_write_b32 a24, 0
    v_accvgpr_write_b32 a25, 0
    v_accvgpr_write_b32 a28, 0
    v_accvgpr_write_b32 a29, 0
    v_accvgpr_write_b32 a32, 0
    v_accvgpr_write_b32 a33, 0
    v_accvgpr_write_b32 a36, 0
    v_accvgpr_write_b32 a37, 0
    v_accvgpr_write_b32 a40, 0
    v_accvgpr_write_b32 a41, 0
    v_accvgpr_write_b32 a44, 0
    v_accvgpr_write_b32 a45, 0
    v_accvgpr_write_b32 a48, 0
    v_accvgpr_write_b32 a49, 0
    v_accvgpr_write_b32 a52, 0
    v_accvgpr_write_b32 a53, 0
    v_accvgpr_write_b32 a56, 0
    v_accvgpr_write_b32 a57, 0
    v_accvgpr_write_b32 a60, 0
    v_accvgpr_write_b32 a61, 0
.p2align 6
L_K:
    s_mov_b32 s58, 0x8001
    s_bitcmp0_b32 s58, s45
    s_cselect_b64 vcc, 1, 0
    s_barrier
    s_cbranch_vccz L_S1
    s_waitcnt vmcnt(6)
L_S1:
    s_waitcnt vmcnt(9)
    buffer_load_dwordx4 v[48:51], v1, s[20:23], s47 offen offset:0 nt
    v_mfma_f32_16x16x32_bf16 v[204:207], v[236:239], v[108:111], v[204:207]
    v_mfma_f32_16x16x32_bf16 v[220:223], v[244:247], v[108:111], v[220:223]
    v_mfma_f32_16x16x32_bf16 v[204:207], v[240:243], v[108:111], v[204:207]
    v_mfma_f32_16x16x32_bf16 v[220:223], v[248:251], v[108:111], v[220:223]
    s_add_u32 s60, s50, 0x0
    buffer_load_dwordx4 v[108:111], v2, s[28:31], s60 offen
    v_dot2_f32_bf16 v80, v16, v4, 0
    v_dot2_f32_bf16 v80, v17, v5, v80
    v_dot2_f32_bf16 v80, v18, v6, v80
    v_dot2_f32_bf16 v80, v19, v7, v80
    s_cbranch_vccz L_S2
    s_waitcnt vmcnt(7)
L_S2:
    s_waitcnt vmcnt(9)
    buffer_load_dwordx4 v[52:55], v1, s[20:23], s47 offen offset:256 nt
    v_dot2_f32_bf16 v81, v20, v4, 0
    v_dot2_f32_bf16 v81, v21, v5, v81
    v_dot2_f32_bf16 v81, v22, v6, v81
    v_dot2_f32_bf16 v81, v23, v7, v81
    s_nop 2
    v_cvt_pk_bf16_f32 v92, v80, v81
    v_lshlrev_b32 v88, 16, v92
    v_and_b32 v89, s62, v92
    v_sub_f32 v88, v80, v88
    v_sub_f32 v89, v81, v89
    v_cvt_pk_bf16_f32 v96, v88, v89
    s_cbranch_vccz L_S3
    s_waitcnt vmcnt(7)
L_S3:
    s_waitcnt vmcnt(9)
    buffer_load_dwordx4 v[56:59], v1, s[20:23], s47 offen offset:512 nt
    buffer_load_dwordx4 v[156:159], v3, s[32:35], s51 offen
    v_dot2_f32_bf16 v82, v24, v4, 0
    v_dot2_f32_bf16 v82, v25, v5, v82
    v_dot2_f32_bf16 v82, v26, v6, v82
    v_dot2_f32_bf16 v82, v27, v7, v82
    s_cbranch_vccz L_S4
    s_waitcnt vmcnt(7)
L_S4:
    s_waitcnt vmcnt(10)
    buffer_load_dwordx4 v[60:63], v1, s[20:23], s47 offen offset:768 nt
    v_dot2_f32_bf16 v83, v28, v4, 0
    v_dot2_f32_bf16 v83, v29, v5, v83
    v_dot2_f32_bf16 v83, v30, v6, v83
    v_dot2_f32_bf16 v83, v31, v7, v83
    s_nop 2
    v_cvt_pk_bf16_f32 v93, v82, v83
    v_lshlrev_b32 v88, 16, v93
    v_and_b32 v89, s62, v93
    v_sub_f32 v88, v82, v88
    v_sub_f32 v89, v83, v89
    v_cvt_pk_bf16_f32 v97, v88, v89
    s_cbranch_vccz L_S5
    s_waitcnt vmcnt(7)
L_S5:
    s_waitcnt vmcnt(10)
    buffer_load_dwordx4 v[64:67], v1, s[20:23], s47 offen offset:1024 nt
    v_mfma_f32_16x16x32_bf16 v[208:211], v[236:239], v[112:115], v[208:211]
    v_mfma_f32_16x16x32_bf16 v[224:227], v[244:247], v[112:115], v[224:227]
    v_mfma_f32_16x16x32_bf16 v[208:211], v[240:243], v[112:115], v[208:211]
    v_mfma_f32_16x16x32_bf16 v[224:227], v[248:251], v[112:115], v[224:227]
    s_add_u32 s60, s50, 0x10000
    buffer_load_dwordx4 v[112:115], v2, s[28:31], s60 offen
    v_dot2_f32_bf16 v84, v32, v4, 0
    v_dot2_f32_bf16 v84, v33, v5, v84
    v_dot2_f32_bf16 v84, v34, v6, v84
    v_dot2_f32_bf16 v84, v35, v7, v84
    s_cbranch_vccz L_S6
    s_waitcnt vmcnt(8)
L_S6:
    s_waitcnt vmcnt(10)
    buffer_load_dwordx4 v[68:71], v1, s[20:23], s47 offen offset:1280 nt
    v_dot2_f32_bf16 v85, v36, v4, 0
    v_dot2_f32_bf16 v85, v37, v5, v85
    v_dot2_f32_bf16 v85, v38, v6, v85
    v_dot2_f32_bf16 v85, v39, v7, v85
    s_nop 2
    v_cvt_pk_bf16_f32 v94, v84, v85
    v_lshlrev_b32 v88, 16, v94
    v_and_b32 v89, s62, v94
    v_sub_f32 v88, v84, v88
    v_sub_f32 v89, v85, v89
    v_cvt_pk_bf16_f32 v98, v88, v89
    s_cbranch_vccz L_S7
    s_waitcnt vmcnt(8)
L_S7:
    s_waitcnt vmcnt(10)
    buffer_load_dwordx4 v[72:75], v1, s[20:23], s47 offen offset:1536 nt
    s_add_u32 s60, s51, 0x1000
    buffer_load_dwordx4 v[160:163], v3, s[32:35], s60 offen
    v_dot2_f32_bf16 v86, v40, v4, 0
    v_dot2_f32_bf16 v86, v41, v5, v86
    v_dot2_f32_bf16 v86, v42, v6, v86
    v_dot2_f32_bf16 v86, v43, v7, v86
    s_cbranch_vccz L_S8
    s_waitcnt vmcnt(8)
L_S8:
    s_waitcnt vmcnt(11)
    buffer_load_dwordx4 v[76:79], v1, s[20:23], s47 offen offset:1792 nt
    v_dot2_f32_bf16 v87, v44, v4, 0
    v_dot2_f32_bf16 v87, v45, v5, v87
    v_dot2_f32_bf16 v87, v46, v6, v87
    v_dot2_f32_bf16 v87, v47, v7, v87
    s_nop 2
    v_cvt_pk_bf16_f32 v95, v86, v87
    v_lshlrev_b32 v88, 16, v95
    v_and_b32 v89, s62, v95
    v_sub_f32 v88, v86, v88
    v_sub_f32 v89, v87, v89
    v_cvt_pk_bf16_f32 v99, v88, v89
    s_cbranch_vccz L_S9
    s_waitcnt vmcnt(8)
L_S9:
    s_waitcnt vmcnt(11)
    buffer_load_dwordx4 v[16:19], v1, s[24:27], s48 offen offset:0 nt
    v_mfma_f32_16x16x32_bf16 v[212:215], v[236:239], v[116:119], v[212:215]
    v_mfma_f32_16x16x32_bf16 v[228:231], v[244:247], v[116:119], v[228:231]
    v_mfma_f32_16x16x32_bf16 v[212:215], v[240:243], v[116:119], v[212:215]
    v_mfma_f32_16x16x32_bf16 v[228:231], v[248:251], v[116:119], v[228:231]
    s_add_u32 s60, s50, 0x20000
    buffer_load_dwordx4 v[116:119], v2, s[28:31], s60 offen
    v_dot2_f32_bf16 v80, v48, v8, 0
    v_dot2_f32_bf16 v80, v49, v9, v80
    v_dot2_f32_bf16 v80, v50, v10, v80
    v_dot2_f32_bf16 v80, v51, v11, v80
    s_cbranch_vccz L_S10
    s_waitcnt vmcnt(8)
L_S10:
    s_waitcnt vmcnt(11)
    buffer_load_dwordx4 v[20:23], v1, s[24:27], s48 offen offset:256 nt
    v_dot2_f32_bf16 v81, v52, v8, 0
    v_dot2_f32_bf16 v81, v53, v9, v81
    v_dot2_f32_bf16 v81, v54, v10, v81
    v_dot2_f32_bf16 v81, v55, v11, v81
    s_nop 2
    v_cvt_pk_bf16_f32 v100, v80, v81
    v_lshlrev_b32 v88, 16, v100
    v_and_b32 v89, s62, v100
    v_sub_f32 v88, v80, v88
    v_sub_f32 v89, v81, v89
    v_cvt_pk_bf16_f32 v104, v88, v89
    s_cbranch_vccz L_S11
    s_waitcnt vmcnt(8)
L_S11:
    s_waitcnt vmcnt(11)
    buffer_load_dwordx4 v[24:27], v1, s[24:27], s48 offen offset:512 nt
    v_dot2_f32_bf16 v82, v56, v8, 0
    v_dot2_f32_bf16 v82, v57, v9, v82
    v_dot2_f32_bf16 v82, v58, v10, v82
    v_dot2_f32_bf16 v82, v59, v11, v82
    s_cbranch_vccz L_S12
    s_waitcnt vmcnt(7)
L_S12:
    s_waitcnt vmcnt(10)
    buffer_load_dwordx4 v[28:31], v1, s[24:27], s48 offen offset:768 nt
    v_dot2_f32_bf16 v83, v60, v8, 0
    v_dot2_f32_bf16 v83, v61, v9, v83
    v_dot2_f32_bf16 v83, v62, v10, v83
    v_dot2_f32_bf16 v83, v63, v11, v83
    s_nop 2
    v_cvt_pk_bf16_f32 v101, v82, v83
    v_lshlrev_b32 v88, 16, v101
    v_and_b32 v89, s62, v101
    v_sub_f32 v88, v82, v88
    v_sub_f32 v89, v83, v89
    v_cvt_pk_bf16_f32 v105, v88, v89
    s_cbranch_vccz L_S13
    s_waitcnt vmcnt(7)
L_S13:
    s_waitcnt vmcnt(10)
    buffer_load_dwordx4 v[32:35], v1, s[24:27], s48 offen offset:1024 nt
    v_mfma_f32_16x16x32_bf16 v[216:219], v[236:239], v[120:123], v[216:219]
    v_mfma_f32_16x16x32_bf16 v[232:235], v[244:247], v[120:123], v[232:235]
    v_mfma_f32_16x16x32_bf16 v[216:219], v[240:243], v[120:123], v[216:219]
    v_mfma_f32_16x16x32_bf16 v[232:235], v[248:251], v[120:123], v[232:235]
    s_add_u32 s60, s50, 0x30000
    buffer_load_dwordx4 v[120:123], v2, s[28:31], s60 offen
    v_dot2_f32_bf16 v84, v64, v8, 0
    v_dot2_f32_bf16 v84, v65, v9, v84
    v_dot2_f32_bf16 v84, v66, v10, v84
    v_dot2_f32_bf16 v84, v67, v11, v84
    s_cbranch_vccz L_S14
    s_waitcnt vmcnt(7)
L_S14:
    s_waitcnt vmcnt(10)
    buffer_load_dwordx4 v[36:39], v1, s[24:27], s48 offen offset:1280 nt
    v_dot2_f32_bf16 v85, v68, v8, 0
    v_dot2_f32_bf16 v85, v69, v9, v85
    v_dot2_f32_bf16 v85, v70, v10, v85
    v_dot2_f32_bf16 v85, v71, v11, v85
    s_nop 2
    v_cvt_pk_bf16_f32 v102, v84, v85
    v_lshlrev_b32 v88, 16, v102
    v_and_b32 v89, s62, v102
    v_sub_f32 v88, v84, v88
    v_sub_f32 v89, v85, v89
    v_cvt_pk_bf16_f32 v106, v88, v89
    s_cbranch_vccz L_S15
    s_waitcnt vmcnt(7)
L_S15:
    s_waitcnt vmcnt(10)
    buffer_load_dwordx4 v[40:43], v1, s[24:27], s48 offen offset:1536 nt
    v_dot2_f32_bf16 v86, v72, v8, 0
    v_dot2_f32_bf16 v86, v73, v9, v86
    v_dot2_f32_bf16 v86, v74, v10, v86
    v_dot2_f32_bf16 v86, v75, v11, v86
    s_cbranch_vccz L_S16
    s_waitcnt vmcnt(6)
L_S16:
    s_waitcnt vmcnt(9)
    buffer_load_dwordx4 v[44:47], v1, s[24:27], s48 offen offset:1792 nt
    v_dot2_f32_bf16 v87, v76, v8, 0
    v_dot2_f32_bf16 v87, v77, v9, v87
    v_dot2_f32_bf16 v87, v78, v10, v87
    v_dot2_f32_bf16 v87, v79, v11, v87
    s_nop 2
    v_cvt_pk_bf16_f32 v103, v86, v87
    v_lshlrev_b32 v88, 16, v103
    v_and_b32 v89, s62, v103
    v_sub_f32 v88, v86, v88
    v_sub_f32 v89, v87, v89
    v_cvt_pk_bf16_f32 v107, v88, v89
    v_mov_b32 v236, v92
    v_mov_b32 v237, v93
    v_mov_b32 v238, v94
    v_mov_b32 v239, v95
    v_mov_b32 v240, v96
    v_mov_b32 v241, v97
    v_mov_b32 v242, v98
    v_mov_b32 v243, v99
    v_mov_b32 v244, v100
    v_mov_b32 v245, v101
    v_mov_b32 v246, v102
    v_mov_b32 v247, v103
    v_mov_b32 v248, v104
    v_mov_b32 v249, v105
    v_mov_b32 v250, v106
    v_mov_b32 v251, v107
    s_add_u32 s45, s45, 1
    s_mov_b32 s46, s48
    s_mov_b32 s47, s49
    s_mov_b32 s20, s24
    s_mov_b32 s21, s25
    s_add_u32 s48, s48, 0x8000
    s_add_u32 s49, s49, 0x8000
    s_add_u32 s50, s50, 256
    s_cmp_lt_u32 s45, 3
    s_cbranch_scc1 L_K
    s_cmp_le_u32 s45, 11
    s_cbranch_scc1 L_KPERM
    s_cmp_lt_u32 s45, 15
    s_cbranch_scc1 L_K
    s_cmp_eq_u32 s45, 16
    s_cbranch_scc1 L_TRANS
    s_mov_b32 s24, s56
    s_mov_b32 s25, s57
    s_mov_b32 s48, 0
    s_mov_b32 s49, 0x80000
    s_mov_b32 s51, 0x400
    s_branch L_K
L_KPERM:
    s_mov_b32 s51, 0
    s_cmp_eq_u32 s45, 3
    s_cbranch_scc1 L_K
    v_perm_b32 v172, v160, v156, s54
    v_perm_b32 v174, v160, v156, s55
    v_perm_b32 v176, v161, v157, s54
    v_perm_b32 v178, v161, v157, s55
    v_perm_b32 v180, v162, v158, s54
    v_perm_b32 v182, v162, v158, s55
    v_perm_b32 v184, v163, v159, s54
    v_perm_b32 v186, v163, v159, s55
    s_cmp_lg_u32 s45, 4
    s_cbranch_scc1 L_KP1
    v_accvgpr_write_b32 a64, v172
    v_accvgpr_write_b32 a68, v174
    v_accvgpr_write_b32 a72, v176
    v_accvgpr_write_b32 a76, v178
    v_accvgpr_write_b32 a80, v180
    v_accvgpr_write_b32 a84, v182
    v_accvgpr_write_b32 a88, v184
    v_accvgpr_write_b32 a92, v186
    s_mov_b32 s51, 0x2000
    s_branch L_K
L_KP1:
    s_cmp_lg_u32 s45, 5
    s_cbranch_scc1 L_KP2
    v_accvgpr_write_b32 a65, v172
    v_accvgpr_write_b32 a69, v174
    v_accvgpr_write_b32 a73, v176
    v_accvgpr_write_b32 a77, v178
    v_accvgpr_write_b32 a81, v180
    v_accvgpr_write_b32 a85, v182
    v_accvgpr_write_b32 a89, v184
    v_accvgpr_write_b32 a93, v186
    s_mov_b32 s51, 0x10000
    s_branch L_K
L_KP2:
    s_cmp_lg_u32 s45, 6
    s_cbranch_scc1 L_KP3
    v_accvgpr_write_b32 a66, v172
    v_accvgpr_write_b32 a70, v174
    v_accvgpr_write_b32 a74, v176
    v_accvgpr_write_b32 a78, v178
    v_accvgpr_write_b32 a82, v180
    v_accvgpr_write_b32 a86, v182
    v_accvgpr_write_b32 a90, v184
    v_accvgpr_write_b32 a94, v186
    s_mov_b32 s51, 0x12000
    s_branch L_K
L_KP3:
    s_cmp_lg_u32 s45, 7
    s_cbranch_scc1 L_KP4
    v_accvgpr_write_b32 a67, v172
    v_accvgpr_write_b32 a71, v174
    v_accvgpr_write_b32 a75, v176
    v_accvgpr_write_b32 a79, v178
    v_accvgpr_write_b32 a83, v180
    v_accvgpr_write_b32 a87, v182
    v_accvgpr_write_b32 a91, v184
    v_accvgpr_write_b32 a95, v186
    s_mov_b32 s51, 0x20000
    s_branch L_K
L_KP4:
    s_cmp_lg_u32 s45, 8
    s_cbranch_scc1 L_KP5
    v_accvgpr_write_b32 a96, v172
    v_accvgpr_write_b32 a100, v174
    v_accvgpr_write_b32 a104, v176
    v_accvgpr_write_b32 a108, v178
    v_accvgpr_write_b32 a112, v180
    v_accvgpr_write_b32 a116, v182
    v_accvgpr_write_b32 a120, v184
    v_accvgpr_write_b32 a124, v186
    s_mov_b32 s51, 0x22000
    s_branch L_K
L_KP5:
    s_cmp_lg_u32 s45, 9
    s_cbranch_scc1 L_KP6
    v_accvgpr_write_b32 a97, v172
    v_accvgpr_write_b32 a101, v174
    v_accvgpr_write_b32 a105, v176
    v_accvgpr_write_b32 a109, v178
    v_accvgpr_write_b32 a113, v180
    v_accvgpr_write_b32 a117, v182
    v_accvgpr_write_b32 a121, v184
    v_accvgpr_write_b32 a125, v186
    s_mov_b32 s51, 0x30000
    s_branch L_K
L_KP6:
    s_cmp_lg_u32 s45, 10
    s_cbranch_scc1 L_KP7
    v_accvgpr_write_b32 a98, v172
    v_accvgpr_write_b32 a102, v174
    v_accvgpr_write_b32 a106, v176
    v_accvgpr_write_b32 a110, v178
    v_accvgpr_write_b32 a114, v180
    v_accvgpr_write_b32 a118, v182
    v_accvgpr_write_b32 a122, v184
    v_accvgpr_write_b32 a126, v186
    s_mov_b32 s51, 0x32000
    s_branch L_K
L_KP7:
    v_accvgpr_write_b32 a99, v172
    v_accvgpr_write_b32 a103, v174
    v_accvgpr_write_b32 a107, v176
    v_accvgpr_write_b32 a111, v178
    v_accvgpr_write_b32 a115, v180
    v_accvgpr_write_b32 a119, v182
    v_accvgpr_write_b32 a123, v184
    v_accvgpr_write_b32 a127, v186
    s_mov_b32 s51, 0x40000000
    s_branch L_K
L_TRANS:
    s_add_u32 s60, s51, 0x2000
    buffer_load_dwordx4 v[164:167], v3, s[32:35], s60 offen
    s_add_u32 s60, s51, 0x3000
    buffer_load_dwordx4 v[168:171], v3, s[32:35], s60 offen
    v_mfma_f32_16x16x32_bf16 v[204:207], v[236:239], v[108:111], v[204:207]
    v_mfma_f32_16x16x32_bf16 v[220:223], v[244:247], v[108:111], v[220:223]
    v_mfma_f32_16x16x32_bf16 v[204:207], v[240:243], v[108:111], v[204:207]
    v_mfma_f32_16x16x32_bf16 v[220:223], v[248:251], v[108:111], v[220:223]
    v_mfma_f32_16x16x32_bf16 v[208:211], v[236:239], v[112:115], v[208:211]
    v_mfma_f32_16x16x32_bf16 v[224:227], v[244:247], v[112:115], v[224:227]
    v_mfma_f32_16x16x32_bf16 v[208:211], v[240:243], v[112:115], v[208:211]
    v_mfma_f32_16x16x32_bf16 v[224:227], v[248:251], v[112:115], v[224:227]
    s_waitcnt vmcnt(10)
    v_mfma_f32_16x16x32_bf16 v[212:215], v[236:239], v[116:119], v[212:215]
    v_mfma_f32_16x16x32_bf16 v[228:231], v[244:247], v[116:119], v[228:231]
    v_mfma_f32_16x16x32_bf16 v[212:215], v[240:243], v[116:119], v[212:215]
    v_mfma_f32_16x16x32_bf16 v[228:231], v[248:251], v[116:119], v[228:231]
    s_waitcnt vmcnt(5)
    v_mfma_f32_16x16x32_bf16 v[216:219], v[236:239], v[120:123], v[216:219]
    v_mfma_f32_16x16x32_bf16 v[232:235], v[244:247], v[120:123], v[232:235]
    v_mfma_f32_16x16x32_bf16 v[216:219], v[240:243], v[120:123], v[216:219]
    v_mfma_f32_16x16x32_bf16 v[232:235], v[248:251], v[120:123], v[232:235]
    buffer_load_dwordx4 v[48:51], v1, s[20:23], s47 offen offset:0 nt
    buffer_load_dwordx4 v[52:55], v1, s[20:23], s47 offen offset:256 nt
    buffer_load_dwordx4 v[56:59], v1, s[20:23], s47 offen offset:512 nt
    buffer_load_dwordx4 v[60:63], v1, s[20:23], s47 offen offset:768 nt
    s_mov_b32 s51, 0x10400
    s_nop 6
    v_add_f32 v204, v204, v205
    v_add_f32 v206, v206, v207
    v_add_f32 v208, v208, v209
    v_add_f32 v210, v210, v211
    v_add_f32 v212, v212, v213
    v_add_f32 v214, v214, v215
    v_add_f32 v216, v216, v217
    v_add_f32 v218, v218, v219
    v_add_f32 v220, v220, v221
    v_add_f32 v222, v222, v223
    v_add_f32 v224, v224, v225
    v_add_f32 v226, v226, v227
    v_add_f32 v228, v228, v229
    v_add_f32 v230, v230, v231
    v_add_f32 v232, v232, v233
    v_add_f32 v234, v234, v235
    v_add_f32 v204, v204, v206
    v_add_f32 v208, v208, v210
    v_add_f32 v212, v212, v214
    v_add_f32 v216, v216, v218
    v_add_f32 v220, v220, v222
    v_add_f32 v224, v224, v226
    v_add_f32 v228, v228, v230
    v_add_f32 v232, v232, v234
    s_nop 1
    v_permlane32_swap_b32 v204, v212
    v_permlane32_swap_b32 v208, v216
    v_permlane32_swap_b32 v220, v228
    v_permlane32_swap_b32 v224, v232
    s_nop 1
    v_add_f32 v204, v204, v212
    v_add_f32 v208, v208, v216
    v_add_f32 v220, v220, v228
    v_add_f32 v224, v224, v232
    s_nop 1
    v_permlane16_swap_b32 v204, v208
    v_permlane16_swap_b32 v220, v224
    s_nop 1
    v_add_f32 v204, v204, v208
    v_add_f32 v220, v220, v224
    s_lshl_b32 s60, s44, 2
    v_lshlrev_b32 v15, 4, v0
    v_add_u32 v88, s60, v15
    ds_write_b32 v88, v204 offset:0
    ds_write_b32 v88, v220 offset:1024
    s_waitcnt lgkmcnt(0)
    s_barrier
    ds_read_b128 v[80:83], v15 offset:0
    ds_read_b128 v[84:87], v15 offset:1024
    buffer_load_dwordx4 v[64:67], v1, s[20:23], s47 offen offset:1024 nt
    buffer_load_dwordx4 v[68:71], v1, s[20:23], s47 offen offset:1280 nt
    buffer_load_dwordx4 v[72:75], v1, s[20:23], s47 offen offset:1536 nt
    buffer_load_dwordx4 v[76:79], v1, s[20:23], s47 offen offset:1792 nt
    s_mov_b32 s61, 0x3e0293ee
    s_waitcnt lgkmcnt(0)
    v_add_f32 v80, v80, v81
    v_add_f32 v82, v82, v83
    v_add_f32 v84, v84, v85
    v_add_f32 v86, v86, v87
    v_add_f32 v80, v80, v82
    v_add_f32 v84, v84, v86
    v_mul_f32 v80, s61, v80
    v_mul_f32 v84, s61, v84
    s_nop 0
    v_max_f32_dpp v81, v80, v80 quad_perm:[1,0,3,2] row_mask:0xf bank_mask:0xf
    v_max_f32_dpp v85, v84, v84 quad_perm:[1,0,3,2] row_mask:0xf bank_mask:0xf
    s_nop 0
    v_max_f32_dpp v81, v81, v81 quad_perm:[2,3,0,1] row_mask:0xf bank_mask:0xf
    v_max_f32_dpp v85, v85, v85 quad_perm:[2,3,0,1] row_mask:0xf bank_mask:0xf
    s_nop 0
    v_max_f32_dpp v81, v81, v81 row_half_mirror row_mask:0xf bank_mask:0xf
    v_max_f32_dpp v85, v85, v85 row_half_mirror row_mask:0xf bank_mask:0xf
    s_nop 0
    v_max_f32_dpp v81, v81, v81 row_mirror row_mask:0xf bank_mask:0xf
    v_max_f32_dpp v85, v85, v85 row_mirror row_mask:0xf bank_mask:0xf
    s_nop 0
    v_mov_b32 v82, v81
    v_mov_b32 v86, v85
    s_nop 1
    v_permlane16_swap_b32 v81, v82
    v_permlane16_swap_b32 v85, v86
    s_nop 1
    v_max_f32 v81, v81, v82
    v_max_f32 v85, v85, v86
    v_mov_b32 v82, v81
    v_mov_b32 v86, v85
    s_nop 1
    v_permlane32_swap_b32 v81, v82
    v_permlane32_swap_b32 v85, v86
    s_nop 1
    v_max_f32 v81, v81, v82
    v_max_f32 v85, v85, v86
    v_sub_f32 v80, v80, v81
    v_sub_f32 v84, v84, v85
    v_exp_f32 v80, v80
    v_exp_f32 v84, v84
    s_nop 0
    s_nop 0
    v_add_f32_dpp v81, v80, v80 quad_perm:[1,0,3,2] row_mask:0xf bank_mask:0xf
    v_add_f32_dpp v85, v84, v84 quad_perm:[1,0,3,2] row_mask:0xf bank_mask:0xf
    s_nop 0
    v_add_f32_dpp v81, v81, v81 quad_perm:[2,3,0,1] row_mask:0xf bank_mask:0xf
    v_add_f32_dpp v85, v85, v85 quad_perm:[2,3,0,1] row_mask:0xf bank_mask:0xf
    s_nop 0
    v_add_f32_dpp v81, v81, v81 row_half_mirror row_mask:0xf bank_mask:0xf
    v_add_f32_dpp v85, v85, v85 row_half_mirror row_mask:0xf bank_mask:0xf
    s_nop 0
    v_add_f32_dpp v81, v81, v81 row_mirror row_mask:0xf bank_mask:0xf
    v_add_f32_dpp v85, v85, v85 row_mirror row_mask:0xf bank_mask:0xf
    s_nop 0
    v_mov_b32 v82, v81
    v_mov_b32 v86, v85
    s_nop 1
    v_permlane16_swap_b32 v81, v82
    v_permlane16_swap_b32 v85, v86
    s_nop 1
    v_add_f32 v81, v81, v82
    v_add_f32 v85, v85, v86
    v_mov_b32 v82, v81
    v_mov_b32 v86, v85
    s_nop 1
    v_permlane32_swap_b32 v81, v82
    v_permlane32_swap_b32 v85, v86
    s_nop 1
    v_add_f32 v81, v81, v82
    v_add_f32 v85, v85, v86
    v_rcp_f32 v81, v81
    v_rcp_f32 v85, v85
    s_nop 0
    v_mul_f32 v80, v80, v81
    v_mul_f32 v84, v84, v85
    v_cvt_pk_bf16_f32 v81, v80, v84
    v_lshlrev_b32 v82, 16, v81
    v_and_b32 v86, s62, v81
    v_sub_f32 v82, v80, v82
    v_sub_f32 v86, v84, v86
    v_cvt_pk_bf16_f32 v85, v82, v86
    s_lshl_b32 s60, s44, 9
    v_lshlrev_b32 v15, 1, v0
    v_add_u32 v15, s60, v15
    ds_write_b16 v15, v81 offset:2048
    ds_write_b16 v15, v85 offset:2176
    ds_write_b16_d16_hi v15, v81 offset:2304
    ds_write_b16_d16_hi v15, v85 offset:2432
    s_waitcnt lgkmcnt(0)
    ds_read_b64 v[196:197], v14 offset:0
    ds_read_b64 v[198:199], v14 offset:32
    ds_read_b64 v[200:201], v14 offset:64
    ds_read_b64 v[202:203], v14 offset:96
    s_mov_b32 s45, 0
    s_waitcnt lgkmcnt(0)
    v_mfma_f32_16x16x32_bf16 v[204:207], v[196:199], a[64:67], 0
    v_mfma_f32_16x16x32_bf16 v[208:211], v[196:199], a[68:71], 0
    v_mfma_f32_16x16x32_bf16 v[212:215], v[196:199], a[72:75], 0
    v_mfma_f32_16x16x32_bf16 v[216:219], v[196:199], a[76:79], 0
    v_mfma_f32_16x16x32_bf16 v[220:223], v[196:199], a[80:83], 0
    v_mfma_f32_16x16x32_bf16 v[224:227], v[196:199], a[84:87], 0
    v_mfma_f32_16x16x32_bf16 v[228:231], v[196:199], a[88:91], 0
    v_mfma_f32_16x16x32_bf16 v[232:235], v[196:199], a[92:95], 0
    v_mfma_f32_16x16x32_bf16 v[204:207], v[200:203], a[96:99], v[204:207]
    v_mfma_f32_16x16x32_bf16 v[208:211], v[200:203], a[100:103], v[208:211]
    v_mfma_f32_16x16x32_bf16 v[212:215], v[200:203], a[104:107], v[212:215]
    v_mfma_f32_16x16x32_bf16 v[216:219], v[200:203], a[108:111], v[216:219]
    v_mfma_f32_16x16x32_bf16 v[220:223], v[200:203], a[112:115], v[220:223]
    v_mfma_f32_16x16x32_bf16 v[224:227], v[200:203], a[116:119], v[224:227]
    v_mfma_f32_16x16x32_bf16 v[228:231], v[200:203], a[120:123], v[228:231]
    v_mfma_f32_16x16x32_bf16 v[232:235], v[200:203], a[124:127], v[232:235]
    s_branch L_WFIN
.p2align 6
L_V0:
    s_mov_b32 s58, 0xf001
    s_bitcmp0_b32 s58, s45
    s_cselect_b64 vcc, 1, 0
    ds_read_b128 v[188:191], v12
    ds_read_b128 v[192:195], v12 offset:8320
    s_and_b32 s60, s45, 3
    s_lshl_b32 s60, s60, 5
    v_add_u32 v15, s60, v14
    ds_read_b64 v[196:197], v15
    v_add_u32 v12, 0x100, v12
    s_waitcnt vmcnt(8)
    v_perm_b32 v172, v160, v156, s54
    v_perm_b32 v174, v160, v156, s55
    v_perm_b32 v176, v161, v157, s54
    v_perm_b32 v178, v161, v157, s55
    v_perm_b32 v180, v162, v158, s54
    v_perm_b32 v182, v162, v158, s55
    v_perm_b32 v184, v163, v159, s54
    v_perm_b32 v186, v163, v159, s55
    buffer_load_dwordx4 v[156:159], v3, s[32:35], s51 offen
    v_perm_b32 v124, v20, v16, s54
    v_perm_b32 v128, v20, v16, s55
    v_perm_b32 v132, v21, v17, s54
    v_perm_b32 v136, v21, v17, s55
    v_perm_b32 v140, v22, v18, s54
    v_perm_b32 v144, v22, v18, s55
    v_perm_b32 v148, v23, v19, s54
    v_perm_b32 v152, v23, v19, s55
    v_perm_b32 v125, v28, v24, s54
    v_perm_b32 v129, v28, v24, s55
    v_perm_b32 v133, v29, v25, s54
    v_perm_b32 v137, v29, v25, s55
    v_perm_b32 v141, v30, v26, s54
    v_perm_b32 v145, v30, v26, s55
    v_perm_b32 v149, v31, v27, s54
    v_perm_b32 v153, v31, v27, s55
    s_add_u32 s60, s51, 0x1000
    buffer_load_dwordx4 v[160:163], v3, s[32:35], s60 offen
    v_perm_b32 v126, v36, v32, s54
    v_perm_b32 v130, v36, v32, s55
    v_perm_b32 v134, v37, v33, s54
    v_perm_b32 v138, v37, v33, s55
    v_perm_b32 v142, v38, v34, s54
    v_perm_b32 v146, v38, v34, s55
    v_perm_b32 v150, v39, v35, s54
    v_perm_b32 v154, v39, v35, s55
    v_perm_b32 v127, v44, v40, s54
    v_perm_b32 v131, v44, v40, s55
    v_perm_b32 v135, v45, v41, s54
    v_perm_b32 v139, v45, v41, s55
    v_perm_b32 v143, v46, v42, s54
    v_perm_b32 v147, v46, v42, s55
    v_perm_b32 v151, v47, v43, s54
    v_perm_b32 v155, v47, v43, s55
    s_waitcnt lgkmcnt(0)
    s_nop 0
    v_mfma_f32_16x16x32_bf16 a[0:3], v[188:191], v[124:127], a[0:3]
    v_mfma_f32_16x16x32_bf16 a[4:7], v[188:191], v[128:131], a[4:7]
    v_mfma_f32_16x16x32_bf16 a[8:11], v[188:191], v[132:135], a[8:11]
    v_mfma_f32_16x16x32_bf16 a[12:15], v[188:191], v[136:139], a[12:15]
    v_mfma_f32_16x16x32_bf16 a[16:19], v[188:191], v[140:143], a[16:19]
    v_mfma_f32_16x16x32_bf16 a[20:23], v[188:191], v[144:147], a[20:23]
    v_mfma_f32_16x16x32_bf16 a[24:27], v[188:191], v[148:151], a[24:27]
    v_mfma_f32_16x16x32_bf16 a[28:31], v[188:191], v[152:155], a[28:31]
    s_branch L_VY
.p2align 6
L_V:
    s_barrier
    s_mov_b32 s58, 0xf001
    s_bitcmp0_b32 s58, s45
    s_cselect_b64 vcc, 1, 0
    ds_read_b128 v[188:191], v12
    ds_read_b128 v[192:195], v12 offset:8320
    s_and_b32 s60, s45, 3
    s_lshl_b32 s60, s60, 5
    v_add_u32 v15, s60, v14
    ds_read_b64 v[196:197], v15
    v_add_u32 v12, 0x100, v12
    s_cbranch_vccz L_S17
    s_waitcnt vmcnt(6)
L_S17:
    s_waitcnt vmcnt(9)
    buffer_load_dwordx4 v[48:51], v1, s[20:23], s47 offen offset:0 nt
    v_perm_b32 v172, v160, v156, s54
    v_perm_b32 v174, v160, v156, s55
    v_perm_b32 v176, v161, v157, s54
    v_perm_b32 v178, v161, v157, s55
    v_perm_b32 v180, v162, v158, s54
    v_perm_b32 v182, v162, v158, s55
    v_perm_b32 v184, v163, v159, s54
    v_perm_b32 v186, v163, v159, s55
    buffer_load_dwordx4 v[156:159], v3, s[32:35], s51 offen
    s_cbranch_vccz L_S18
    s_waitcnt vmcnt(7)
L_S18:
    s_waitcnt vmcnt(9)
    buffer_load_dwordx4 v[52:55], v1, s[20:23], s47 offen offset:256 nt
    v_perm_b32 v124, v20, v16, s54
    v_perm_b32 v128, v20, v16, s55
    v_perm_b32 v132, v21, v17, s54
    v_perm_b32 v136, v21, v17, s55
    v_perm_b32 v140, v22, v18, s54
    v_perm_b32 v144, v22, v18, s55
    v_perm_b32 v148, v23, v19, s54
    v_perm_b32 v152, v23, v19, s55
    s_cbranch_vccz L_S19
    s_waitcnt vmcnt(7)
L_S19:
    s_waitcnt vmcnt(9)
    buffer_load_dwordx4 v[56:59], v1, s[20:23], s47 offen offset:512 nt
    s_cbranch_vccz L_S20
    s_waitcnt vmcnt(6)
L_S20:
    s_waitcnt vmcnt(9)
    buffer_load_dwordx4 v[60:63], v1, s[20:23], s47 offen offset:768 nt
    v_perm_b32 v125, v28, v24, s54
    v_perm_b32 v129, v28, v24, s55
    v_perm_b32 v133, v29, v25, s54
    v_perm_b32 v137, v29, v25, s55
    v_perm_b32 v141, v30, v26, s54
    v_perm_b32 v145, v30, v26, s55
    v_perm_b32 v149, v31, v27, s54
    v_perm_b32 v153, v31, v27, s55
    s_cbranch_vccz L_S21
    s_waitcnt vmcnt(6)
L_S21:
    s_waitcnt vmcnt(9)
    buffer_load_dwordx4 v[64:67], v1, s[20:23], s47 offen offset:1024 nt
    s_add_u32 s60, s51, 0x1000
    buffer_load_dwordx4 v[160:163], v3, s[32:35], s60 offen
    s_cbranch_vccz L_S22
    s_waitcnt vmcnt(7)
L_S22:
    s_waitcnt vmcnt(9)
    buffer_load_dwordx4 v[68:71], v1, s[20:23], s47 offen offset:1280 nt
    v_perm_b32 v126, v36, v32, s54
    v_perm_b32 v130, v36, v32, s55
    v_perm_b32 v134, v37, v33, s54
    v_perm_b32 v138, v37, v33, s55
    v_perm_b32 v142, v38, v34, s54
    v_perm_b32 v146, v38, v34, s55
    v_perm_b32 v150, v39, v35, s54
    v_perm_b32 v154, v39, v35, s55
    s_cbranch_vccz L_S23
    s_waitcnt vmcnt(7)
L_S23:
    s_waitcnt vmcnt(9)
    buffer_load_dwordx4 v[72:75], v1, s[20:23], s47 offen offset:1536 nt
    s_cbranch_vccz L_S24
    s_waitcnt vmcnt(6)
L_S24:
    s_waitcnt vmcnt(9)
    buffer_load_dwordx4 v[76:79], v1, s[20:23], s47 offen offset:1792 nt
    v_perm_b32 v127, v44, v40, s54
    v_perm_b32 v131, v44, v40, s55
    v_perm_b32 v135, v45, v41, s54
    v_perm_b32 v139, v45, v41, s55
    v_perm_b32 v143, v46, v42, s54
    v_perm_b32 v147, v46, v42, s55
    v_perm_b32 v151, v47, v43, s54
    v_perm_b32 v155, v47, v43, s55
    s_waitcnt lgkmcnt(0)
    s_nop 0
    v_mfma_f32_16x16x32_bf16 a[0:3], v[188:191], v[124:127], a[0:3]
    v_mfma_f32_16x16x32_bf16 a[4:7], v[188:191], v[128:131], a[4:7]
    v_mfma_f32_16x16x32_bf16 a[8:11], v[188:191], v[132:135], a[8:11]
    v_mfma_f32_16x16x32_bf16 a[12:15], v[188:191], v[136:139], a[12:15]
    v_mfma_f32_16x16x32_bf16 a[16:19], v[188:191], v[140:143], a[16:19]
    v_mfma_f32_16x16x32_bf16 a[20:23], v[188:191], v[144:147], a[20:23]
    v_mfma_f32_16x16x32_bf16 a[24:27], v[188:191], v[148:151], a[24:27]
    v_mfma_f32_16x16x32_bf16 a[28:31], v[188:191], v[152:155], a[28:31]
L_VY:
    s_cbranch_vccz L_S25
    s_waitcnt vmcnt(6)
L_S25:
    s_waitcnt vmcnt(9)
    buffer_load_dwordx4 v[16:19], v1, s[24:27], s48 offen offset:0 nt
    v_perm_b32 v173, v168, v164, s54
    v_perm_b32 v175, v168, v164, s55
    v_perm_b32 v177, v169, v165, s54
    v_perm_b32 v179, v169, v165, s55
    v_perm_b32 v181, v170, v166, s54
    v_perm_b32 v183, v170, v166, s55
    v_perm_b32 v185, v171, v167, s54
    v_perm_b32 v187, v171, v167, s55
    s_add_u32 s60, s51, 0x2000
    buffer_load_dwordx4 v[164:167], v3, s[32:35], s60 offen
    v_mfma_f32_16x16x16_bf16 v[204:207], v[196:197], v[172:173], v[204:207]
    v_mfma_f32_16x16x16_bf16 v[208:211], v[196:197], v[174:175], v[208:211]
    v_mfma_f32_16x16x16_bf16 v[212:215], v[196:197], v[176:177], v[212:215]
    v_mfma_f32_16x16x16_bf16 v[216:219], v[196:197], v[178:179], v[216:219]
    v_mfma_f32_16x16x16_bf16 v[220:223], v[196:197], v[180:181], v[220:223]
    v_mfma_f32_16x16x16_bf16 v[224:227], v[196:197], v[182:183], v[224:227]
    v_mfma_f32_16x16x16_bf16 v[228:231], v[196:197], v[184:185], v[228:231]
    v_mfma_f32_16x16x16_bf16 v[232:235], v[196:197], v[186:187], v[232:235]
    s_cbranch_vccz L_S26
    s_waitcnt vmcnt(7)
L_S26:
    s_waitcnt vmcnt(9)
    buffer_load_dwordx4 v[20:23], v1, s[24:27], s48 offen offset:256 nt
    v_perm_b32 v124, v52, v48, s54
    v_perm_b32 v128, v52, v48, s55
    v_perm_b32 v132, v53, v49, s54
    v_perm_b32 v136, v53, v49, s55
    v_perm_b32 v140, v54, v50, s54
    v_perm_b32 v144, v54, v50, s55
    v_perm_b32 v148, v55, v51, s54
    v_perm_b32 v152, v55, v51, s55
    s_cbranch_vccz L_S27
    s_waitcnt vmcnt(7)
L_S27:
    s_waitcnt vmcnt(9)
    buffer_load_dwordx4 v[24:27], v1, s[24:27], s48 offen offset:512 nt
    s_cbranch_vccz L_S28
    s_waitcnt vmcnt(6)
L_S28:
    s_waitcnt vmcnt(9)
    buffer_load_dwordx4 v[28:31], v1, s[24:27], s48 offen offset:768 nt
    v_perm_b32 v125, v60, v56, s54
    v_perm_b32 v129, v60, v56, s55
    v_perm_b32 v133, v61, v57, s54
    v_perm_b32 v137, v61, v57, s55
    v_perm_b32 v141, v62, v58, s54
    v_perm_b32 v145, v62, v58, s55
    v_perm_b32 v149, v63, v59, s54
    v_perm_b32 v153, v63, v59, s55
    s_cbranch_vccz L_S29
    s_waitcnt vmcnt(6)
L_S29:
    s_waitcnt vmcnt(9)
    buffer_load_dwordx4 v[32:35], v1, s[24:27], s48 offen offset:1024 nt
    s_add_u32 s60, s51, 0x3000
    buffer_load_dwordx4 v[168:171], v3, s[32:35], s60 offen
    s_cbranch_vccz L_S30
    s_waitcnt vmcnt(7)
L_S30:
    s_waitcnt vmcnt(9)
    buffer_load_dwordx4 v[36:39], v1, s[24:27], s48 offen offset:1280 nt
    v_perm_b32 v126, v68, v64, s54
    v_perm_b32 v130, v68, v64, s55
    v_perm_b32 v134, v69, v65, s54
    v_perm_b32 v138, v69, v65, s55
    v_perm_b32 v142, v70, v66, s54
    v_perm_b32 v146, v70, v66, s55
    v_perm_b32 v150, v71, v67, s54
    v_perm_b32 v154, v71, v67, s55
    s_cbranch_vccz L_S31
    s_waitcnt vmcnt(7)
L_S31:
    s_waitcnt vmcnt(9)
    buffer_load_dwordx4 v[40:43], v1, s[24:27], s48 offen offset:1536 nt
    s_cbranch_vccz L_S32
    s_waitcnt vmcnt(6)
L_S32:
    s_waitcnt vmcnt(9)
    buffer_load_dwordx4 v[44:47], v1, s[24:27], s48 offen offset:1792 nt
    v_perm_b32 v127, v76, v72, s54
    v_perm_b32 v131, v76, v72, s55
    v_perm_b32 v135, v77, v73, s54
    v_perm_b32 v139, v77, v73, s55
    v_perm_b32 v143, v78, v74, s54
    v_perm_b32 v147, v78, v74, s55
    v_perm_b32 v151, v79, v75, s54
    v_perm_b32 v155, v79, v75, s55
    s_nop 0
    s_nop 0
    v_mfma_f32_16x16x32_bf16 a[32:35], v[192:195], v[124:127], a[32:35]
    v_mfma_f32_16x16x32_bf16 a[36:39], v[192:195], v[128:131], a[36:39]
    v_mfma_f32_16x16x32_bf16 a[40:43], v[192:195], v[132:135], a[40:43]
    v_mfma_f32_16x16x32_bf16 a[44:47], v[192:195], v[136:139], a[44:47]
    v_mfma_f32_16x16x32_bf16 a[48:51], v[192:195], v[140:143], a[48:51]
    v_mfma_f32_16x16x32_bf16 a[52:55], v[192:195], v[144:147], a[52:55]
    v_mfma_f32_16x16x32_bf16 a[56:59], v[192:195], v[148:151], a[56:59]
    v_mfma_f32_16x16x32_bf16 a[60:63], v[192:195], v[152:155], a[60:63]
    s_add_u32 s45, s45, 1
    s_mov_b32 s46, s48
    s_mov_b32 s47, s49
    s_add_u32 s48, s48, 0x8000
    s_add_u32 s49, s49, 0x8000
    s_add_u32 s58, s45, 1
    s_and_b32 s61, s58, 3
    s_lshl_b32 s51, s61, 16
    s_lshr_b32 s59, s58, 2
    s_lshl_b32 s59, s59, 10
    s_add_u32 s51, s51, s59
    s_add_u32 s51, s51, 0x400
    s_cmp_ge_u32 s58, 12
    s_cselect_b32 s51, 0x40000000, s51
    s_cmp_eq_u32 s45, 15
    s_cselect_b32 s26, 0, s26
    s_and_b32 s60, s45, 3
    s_cbranch_scc1 L_V
    s_cmp_eq_u32 s45, 16
    s_cbranch_scc1 L_EPI
L_WFIN:
    s_nop 7
    v_add_f32 v80, v204, v205
    v_add_f32 v81, v208, v209
    v_add_f32 v82, v212, v213
    v_add_f32 v83, v216, v217
    v_add_f32 v84, v220, v221
    v_add_f32 v85, v224, v225
    v_add_f32 v86, v228, v229
    v_add_f32 v87, v232, v233
    v_mov_b32 v204, 0
    v_mov_b32 v205, 0
    v_mov_b32 v208, 0
    v_mov_b32 v209, 0
    v_mov_b32 v212, 0
    v_mov_b32 v213, 0
    v_mov_b32 v216, 0
    v_mov_b32 v217, 0
    v_mov_b32 v220, 0
    v_mov_b32 v221, 0
    v_mov_b32 v224, 0
    v_mov_b32 v225, 0
    v_mov_b32 v228, 0
    v_mov_b32 v229, 0
    v_mov_b32 v232, 0
    v_mov_b32 v233, 0
    v_cvt_pk_bf16_f32 v92, v80, v81
    v_lshlrev_b32 v88, 16, v92
    v_and_b32 v89, s62, v92
    v_sub_f32 v88, v80, v88
    v_sub_f32 v89, v81, v89
    v_cvt_pk_bf16_f32 v96, v88, v89
    v_cvt_pk_bf16_f32 v93, v82, v83
    v_lshlrev_b32 v88, 16, v93
    v_and_b32 v89, s62, v93
    v_sub_f32 v88, v82, v88
    v_sub_f32 v89, v83, v89
    v_cvt_pk_bf16_f32 v97, v88, v89
    v_cvt_pk_bf16_f32 v94, v84, v85
    v_lshlrev_b32 v88, 16, v94
    v_and_b32 v89, s62, v94
    v_sub_f32 v88, v84, v88
    v_sub_f32 v89, v85, v89
    v_cvt_pk_bf16_f32 v98, v88, v89
    v_cvt_pk_bf16_f32 v95, v86, v87
    v_lshlrev_b32 v88, 16, v95
    v_and_b32 v89, s62, v95
    v_sub_f32 v88, v86, v88
    v_sub_f32 v89, v87, v89
    v_cvt_pk_bf16_f32 v99, v88, v89
    ds_write_b128 v13, v[92:95]
    ds_write_b128 v13, v[96:99] offset:4160
    v_add_u32 v13, 0x400, v13
    s_waitcnt lgkmcnt(0)
    s_barrier
    s_cmp_eq_u32 s45, 0
    s_cbranch_scc1 L_V0
    s_branch L_V
L_EPI:
    s_nop 7
    v_accvgpr_read_b32 v124, a0
    v_accvgpr_read_b32 v140, a1
    v_accvgpr_read_b32 v125, a4
    v_accvgpr_read_b32 v141, a5
    v_accvgpr_read_b32 v126, a8
    v_accvgpr_read_b32 v142, a9
    v_accvgpr_read_b32 v127, a12
    v_accvgpr_read_b32 v143, a13
    v_accvgpr_read_b32 v128, a16
    v_accvgpr_read_b32 v144, a17
    v_accvgpr_read_b32 v129, a20
    v_accvgpr_read_b32 v145, a21
    v_accvgpr_read_b32 v130, a24
    v_accvgpr_read_b32 v146, a25
    v_accvgpr_read_b32 v131, a28
    v_accvgpr_read_b32 v147, a29
    v_accvgpr_read_b32 v132, a32
    v_accvgpr_read_b32 v148, a33
    v_accvgpr_read_b32 v133, a36
    v_accvgpr_read_b32 v149, a37
    v_accvgpr_read_b32 v134, a40
    v_accvgpr_read_b32 v150, a41
    v_accvgpr_read_b32 v135, a44
    v_accvgpr_read_b32 v151, a45
    v_accvgpr_read_b32 v136, a48
    v_accvgpr_read_b32 v152, a49
    v_accvgpr_read_b32 v137, a52
    v_accvgpr_read_b32 v153, a53
    v_accvgpr_read_b32 v138, a56
    v_accvgpr_read_b32 v154, a57
    v_accvgpr_read_b32 v139, a60
    v_accvgpr_read_b32 v155, a61
    v_add_f32 v124, v124, v140
    v_add_f32 v125, v125, v141
    v_add_f32 v126, v126, v142
    v_add_f32 v127, v127, v143
    v_add_f32 v128, v128, v144
    v_add_f32 v129, v129, v145
    v_add_f32 v130, v130, v146
    v_add_f32 v131, v131, v147
    v_add_f32 v132, v132, v148
    v_add_f32 v133, v133, v149
    v_add_f32 v134, v134, v150
    v_add_f32 v135, v135, v151
    v_add_f32 v136, v136, v152
    v_add_f32 v137, v137, v153
    v_add_f32 v138, v138, v154
    v_add_f32 v139, v139, v155
    s_lshl_b32 s60, s44, 10
    v_lshlrev_b32 v15, 5, v0
    v_add_u32 v15, s60, v15
    s_mov_b64 exec, 0xffff
    ds_write_b128 v15, v[124:127] offset:24576
    ds_write_b128 v15, v[128:131] offset:24592
    ds_write_b128 v15, v[132:135] offset:25088
    ds_write_b128 v15, v[136:139] offset:25104
    s_mov_b64 exec, -1
    s_waitcnt lgkmcnt(0)
    s_barrier
    s_cmp_lg_u32 s44, 0
    s_cbranch_scc1 L_FIN
    v_lshlrev_b32 v15, 4, v0
    ds_read_b128 v[124:127], v15 offset:24576
    ds_read_b128 v[128:131], v15 offset:25600
    ds_read_b128 v[132:135], v15 offset:26624
    ds_read_b128 v[136:139], v15 offset:27648
    v_lshlrev_b32 v15, 3, v0
    s_lshl_b32 s59, s2, 9
    s_waitcnt lgkmcnt(0)
    v_add_f32 v124, v124, v128
    v_add_f32 v132, v132, v136
    v_add_f32 v125, v125, v129
    v_add_f32 v133, v133, v137
    v_add_f32 v126, v126, v130
    v_add_f32 v134, v134, v138
    v_add_f32 v127, v127, v131
    v_add_f32 v135, v135, v139
    v_add_f32 v124, v124, v132
    v_add_f32 v125, v125, v133
    v_add_f32 v126, v126, v134
    v_add_f32 v127, v127, v135
    v_cvt_pk_bf16_f32 v140, v124, v125
    v_cvt_pk_bf16_f32 v141, v126, v127
    buffer_store_dwordx2 v[140:141], v15, s[40:43], s59 offen
L_FIN:
L_END:
    s_endpgm
.section .rodata,"a"
.p2align 6
.amdhsa_kernel standalone__low_rank_proj_linformer__sampling_kernel
  .amdhsa_next_free_vgpr 384
  .amdhsa_next_free_sgpr 96
  .amdhsa_accum_offset 256
  .amdhsa_group_segment_fixed_size 0
  .amdhsa_kernarg_size 64
  .amdhsa_float_denorm_mode_32 3
  .amdhsa_user_sgpr_count 2
  .amdhsa_user_sgpr_kernarg_segment_ptr 1
  .amdhsa_system_sgpr_workgroup_id_x 1
.end_amdhsa_kernel
```
